```python
import torch

def _softmax(x, axis=-1):
    return torch.softmax(x, dim=axis)
def _gelu(x):
    return torch.nn.functional.gelu(x, approximate="tanh")
def _silu(x):
    return torch.nn.functional.silu(x)
def _sigmoid(x):
    return torch.sigmoid(x)
def _layernorm(x, axis=-1, eps=1e-5):
    m = x.mean(dim=axis, keepdim=True)
    v = x.var(dim=axis, keepdim=True, unbiased=False)
    return (x - m) / torch.sqrt(v + eps)
def _scatter_add(tgt, idx, src, axis=0):
    return tgt.clone().index_add_(axis, idx, src)
def _segment_sum(src, seg, n):
    out = torch.zeros((n,) + src.shape[1:], dtype=src.dtype)
    return out.index_add_(0, seg, src)
def _pad(x, pw):
    flat = tuple(v for pair in reversed(pw) for v in pair)
    return torch.nn.functional.pad(x, flat)

kernel_name = 'standalone__rmsnorm__sampling'

def setup_inputs():

    _w = (lambda a: (lambda t: t.to(torch.bfloat16) if t.is_floating_point() else t)(torch.as_tensor(a)))
    B, S, D = 1024, 8, 640
    return {
        "x": _w((lambda *s: torch.randn(*s, dtype=torch.bfloat16) * 0.05)(B, S, D)),
        "g": _w((lambda *s: torch.randn(*s, dtype=torch.bfloat16) * 0.05)(D) + 1.0),
    }

def reference(x, g):
    rms = torch.sqrt((x * x).mean(axis=-1, keepdims=True) + 1e-6)
    return x / rms * g
```

```asm
; @launch grid=(256,1,1) block=(576,1,1) lds=2560
.amdgcn_target "amdgcn-amd-amdhsa--gfx950"
.text
.globl standalone__rmsnorm__sampling_kernel
.p2align 12
.p2align 8
.type standalone__rmsnorm__sampling_kernel,@function
standalone__rmsnorm__sampling_kernel:
    s_load_dwordx8 s[4:11], s[0:1], 0
    s_cmpk_ge_u32 s2, 256
    s_cbranch_scc1 L_end
    v_readfirstlane_b32 s13, v0
    v_and_b32 v1, 15, v0
    v_lshlrev_b32 v1, 4, v1
    s_and_b32 s14, s2, 7
    s_lshr_b32 s15, s2, 3
    s_lshl_b32 s16, s14, 2
    s_lshr_b32 s17, 0x88889995, s16
    s_and_b32 s17, s17, 15
    s_add_u32 s17, s17, 24
    v_lshrrev_b32 v3, 4, v0
    s_lshl_b32 s3, s14, 5
    s_add_u32 s3, s3, s15
    s_lshl_b32 s3, s3, 5
    s_mov_b32 s12, 0xffff0000
    v_mov_b32 v8, 0
    v_mov_b32 v9, 0
    v_mov_b32 v7, 0x3f803f80
    v_mul_u32_u24 v2, 1280, v3
    s_cmpk_eq_u32 s13, 512
    s_cbranch_scc1 L_touch
L_rows:
    s_mulk_i32 s3, 1280
    v_add3_u32 v2, v2, v1, s3
    s_cmp_lg_u32 s13, 64
    s_cbranch_scc1 L_other
    v_and_b32 v0, 63, v0
    v_lshlrev_b32 v3, 4, v0
    v_lshlrev_b32 v4, 2, v0
    v_and_b32 v5, 0xf0, v4
    v_and_b32 v6, 1, v0
    v_lshl_add_u32 v5, v6, 3, v5
    v_bfe_u32 v6, v0, 1, 1
    v_mul_u32_u24 v6, 1280, v6
    v_add_u32 v5, v6, v5
    s_waitcnt lgkmcnt(0)
    global_load_dwordx4 v[72:75], v3, s[6:7]
    global_load_dword v76, v4, s[6:7] offset:1024
    global_load_dwordx4 v[12:15], v2, s[4:5] offset:0 nt
    global_load_dwordx4 v[16:19], v2, s[4:5] offset:256 nt
    global_load_dwordx4 v[20:23], v2, s[4:5] offset:512 nt
    global_load_dwordx4 v[24:27], v2, s[4:5] offset:768 nt
    global_load_dwordx4 v[28:31], v2, s[4:5] offset:1024 nt
    s_waitcnt vmcnt(5)
    v_lshlrev_b32 v32, 16, v72
    v_and_b32 v33, s12, v72
    v_lshlrev_b32 v34, 16, v73
    v_and_b32 v35, s12, v73
    v_lshlrev_b32 v36, 16, v74
    v_and_b32 v37, s12, v74
    v_lshlrev_b32 v38, 16, v75
    v_and_b32 v39, s12, v75
    v_lshlrev_b32 v40, 16, v76
    v_and_b32 v41, s12, v76
    ds_write_b128 v3, v[32:35]
    ds_write_b128 v3, v[36:39] offset:1280
    ds_write_b64 v5, v[40:41] offset:1024
    s_waitcnt lgkmcnt(0)
    s_branch L_join
L_wave8:
    s_lshl_b32 s3, s15, 5
    s_add_u32 s3, s3, s14
    s_sub_u32 s3, s3, 4
    s_branch L_rows
L_other:
    v_cmp_gt_u32 vcc, s17, v3
    s_and_b64 exec, exec, vcc
    s_cbranch_execz L_end
    s_waitcnt lgkmcnt(0)
    global_load_dwordx4 v[12:15], v2, s[4:5] offset:0 nt
    global_load_dwordx4 v[16:19], v2, s[4:5] offset:256 nt
    global_load_dwordx4 v[20:23], v2, s[4:5] offset:512 nt
    global_load_dwordx4 v[24:27], v2, s[4:5] offset:768 nt
    global_load_dwordx4 v[28:31], v2, s[4:5] offset:1024 nt
L_join:
    s_barrier
    global_load_dword v6, v1, s[6:7]
    ds_read_b128 v[32:35], v1 offset:0
    ds_read_b128 v[36:39], v1 offset:1280
    ds_read_b128 v[40:43], v1 offset:256
    ds_read_b128 v[44:47], v1 offset:1536
    ds_read_b128 v[48:51], v1 offset:512
    ds_read_b128 v[52:55], v1 offset:1792
    ds_read_b128 v[56:59], v1 offset:768
    ds_read_b128 v[60:63], v1 offset:2048
    ds_read_b128 v[64:67], v1 offset:1024
    ds_read_b128 v[68:71], v1 offset:2304
    s_cmp_eq_u32 s13, 1
    s_waitcnt vmcnt(5)
    v_lshlrev_b32 v72, 16, v12
    v_and_b32 v73, s12, v12
    v_lshlrev_b32 v74, 16, v13
    v_and_b32 v75, s12, v13
    v_lshlrev_b32 v76, 16, v14
    v_and_b32 v77, s12, v14
    v_lshlrev_b32 v78, 16, v15
    v_and_b32 v79, s12, v15
    v_pk_mul_f32 v[112:113], v[72:73], v[72:73]
    v_pk_mul_f32 v[114:115], v[74:75], v[74:75]
    v_pk_mul_f32 v[116:117], v[76:77], v[76:77]
    v_pk_mul_f32 v[118:119], v[78:79], v[78:79]
    v_cvt_pk_bf16_f32 v112, v112, v113
    v_cvt_pk_bf16_f32 v113, v114, v115
    v_cvt_pk_bf16_f32 v114, v116, v117
    v_cvt_pk_bf16_f32 v115, v118, v119
    v_dot2c_f32_bf16 v8, v112, v7
    v_dot2c_f32_bf16 v9, v113, v7
    v_dot2c_f32_bf16 v8, v114, v7
    v_dot2c_f32_bf16 v9, v115, v7
    s_waitcnt lgkmcnt(0)
    v_pk_mul_f32 v[72:73], v[72:73], v[32:33]
    v_pk_mul_f32 v[74:75], v[74:75], v[34:35]
    v_pk_mul_f32 v[76:77], v[76:77], v[36:37]
    v_pk_mul_f32 v[78:79], v[78:79], v[38:39]
    s_waitcnt vmcnt(4)
    v_lshlrev_b32 v80, 16, v16
    v_and_b32 v81, s12, v16
    v_lshlrev_b32 v82, 16, v17
    v_and_b32 v83, s12, v17
    v_lshlrev_b32 v84, 16, v18
    v_and_b32 v85, s12, v18
    v_lshlrev_b32 v86, 16, v19
    v_and_b32 v87, s12, v19
    v_pk_mul_f32 v[112:113], v[80:81], v[80:81]
    v_pk_mul_f32 v[114:115], v[82:83], v[82:83]
    v_pk_mul_f32 v[116:117], v[84:85], v[84:85]
    v_pk_mul_f32 v[118:119], v[86:87], v[86:87]
    v_cvt_pk_bf16_f32 v112, v112, v113
    v_cvt_pk_bf16_f32 v113, v114, v115
    v_cvt_pk_bf16_f32 v114, v116, v117
    v_cvt_pk_bf16_f32 v115, v118, v119
    v_dot2c_f32_bf16 v8, v112, v7
    v_dot2c_f32_bf16 v9, v113, v7
    v_dot2c_f32_bf16 v8, v114, v7
    v_dot2c_f32_bf16 v9, v115, v7
    v_pk_mul_f32 v[80:81], v[80:81], v[40:41]
    v_pk_mul_f32 v[82:83], v[82:83], v[42:43]
    v_pk_mul_f32 v[84:85], v[84:85], v[44:45]
    v_pk_mul_f32 v[86:87], v[86:87], v[46:47]
    s_waitcnt vmcnt(3)
    v_lshlrev_b32 v88, 16, v20
    v_and_b32 v89, s12, v20
    v_lshlrev_b32 v90, 16, v21
    v_and_b32 v91, s12, v21
    v_lshlrev_b32 v92, 16, v22
    v_and_b32 v93, s12, v22
    v_lshlrev_b32 v94, 16, v23
    v_and_b32 v95, s12, v23
    v_pk_mul_f32 v[112:113], v[88:89], v[88:89]
    v_pk_mul_f32 v[114:115], v[90:91], v[90:91]
    v_pk_mul_f32 v[116:117], v[92:93], v[92:93]
    v_pk_mul_f32 v[118:119], v[94:95], v[94:95]
    v_cvt_pk_bf16_f32 v112, v112, v113
    v_cvt_pk_bf16_f32 v113, v114, v115
    v_cvt_pk_bf16_f32 v114, v116, v117
    v_cvt_pk_bf16_f32 v115, v118, v119
    v_dot2c_f32_bf16 v8, v112, v7
    v_dot2c_f32_bf16 v9, v113, v7
    v_dot2c_f32_bf16 v8, v114, v7
    v_dot2c_f32_bf16 v9, v115, v7
L_touch:
    s_cbranch_scc1 L_wave8
    s_waitcnt vmcnt(2)
    v_lshlrev_b32 v96, 16, v24
    v_and_b32 v97, s12, v24
    v_lshlrev_b32 v98, 16, v25
    v_and_b32 v99, s12, v25
    v_lshlrev_b32 v100, 16, v26
    v_and_b32 v101, s12, v26
    v_lshlrev_b32 v102, 16, v27
    v_and_b32 v103, s12, v27
    v_pk_mul_f32 v[112:113], v[96:97], v[96:97]
    v_pk_mul_f32 v[114:115], v[98:99], v[98:99]
    v_pk_mul_f32 v[116:117], v[100:101], v[100:101]
    v_pk_mul_f32 v[118:119], v[102:103], v[102:103]
    v_cvt_pk_bf16_f32 v112, v112, v113
    v_cvt_pk_bf16_f32 v113, v114, v115
    v_cvt_pk_bf16_f32 v114, v116, v117
    v_cvt_pk_bf16_f32 v115, v118, v119
    v_dot2c_f32_bf16 v8, v112, v7
    v_dot2c_f32_bf16 v9, v113, v7
    v_dot2c_f32_bf16 v8, v114, v7
    v_dot2c_f32_bf16 v9, v115, v7
    s_waitcnt vmcnt(1)
    v_lshlrev_b32 v104, 16, v28
    v_and_b32 v105, s12, v28
    v_lshlrev_b32 v106, 16, v29
    v_and_b32 v107, s12, v29
    v_lshlrev_b32 v108, 16, v30
    v_and_b32 v109, s12, v30
    v_lshlrev_b32 v110, 16, v31
    v_and_b32 v111, s12, v31
    v_pk_mul_f32 v[112:113], v[104:105], v[104:105]
    v_pk_mul_f32 v[114:115], v[106:107], v[106:107]
    v_pk_mul_f32 v[116:117], v[108:109], v[108:109]
    v_pk_mul_f32 v[118:119], v[110:111], v[110:111]
    v_cvt_pk_bf16_f32 v112, v112, v113
    v_cvt_pk_bf16_f32 v113, v114, v115
    v_cvt_pk_bf16_f32 v114, v116, v117
    v_cvt_pk_bf16_f32 v115, v118, v119
    v_dot2c_f32_bf16 v8, v112, v7
    v_dot2c_f32_bf16 v9, v113, v7
    v_dot2c_f32_bf16 v8, v114, v7
    v_dot2c_f32_bf16 v9, v115, v7
    v_pk_mul_f32 v[88:89], v[88:89], v[48:49]
    v_pk_mul_f32 v[90:91], v[90:91], v[50:51]
    v_pk_mul_f32 v[92:93], v[92:93], v[52:53]
    v_add_f32 v8, v8, v9
    v_pk_mul_f32 v[94:95], v[94:95], v[54:55]
    v_pk_mul_f32 v[96:97], v[96:97], v[56:57]
    v_add_f32_dpp v8, v8, v8 quad_perm:[1,0,3,2] row_mask:0xf bank_mask:0xf
    v_pk_mul_f32 v[98:99], v[98:99], v[58:59]
    v_pk_mul_f32 v[100:101], v[100:101], v[60:61]
    v_add_f32_dpp v8, v8, v8 quad_perm:[2,3,0,1] row_mask:0xf bank_mask:0xf
    v_pk_mul_f32 v[102:103], v[102:103], v[62:63]
    v_pk_mul_f32 v[104:105], v[104:105], v[64:65]
    v_add_f32_dpp v8, v8, v8 row_half_mirror row_mask:0xf bank_mask:0xf
    v_pk_mul_f32 v[106:107], v[106:107], v[66:67]
    v_pk_mul_f32 v[108:109], v[108:109], v[68:69]
    v_add_f32_dpp v8, v8, v8 row_mirror row_mask:0xf bank_mask:0xf
    v_mul_f32 v8, 0x3acccccd, v8
    v_cvt_pk_bf16_f32 v8, 0, v8
    v_add_f32 v8, 0x35860000, v8
    v_cvt_pk_bf16_f32 v8, 0, v8
    v_sqrt_f32 v8, v8
    v_pk_mul_f32 v[110:111], v[110:111], v[70:71]
    v_cvt_pk_bf16_f32 v8, 0, v8
    v_rcp_f32 v10, v8
    s_cmp_eq_u32 s13, 0
    v_pk_mul_f32 v[72:73], v[72:73], v[10:11] op_sel_hi:[1,0]
    v_pk_mul_f32 v[74:75], v[74:75], v[10:11] op_sel_hi:[1,0]
    v_pk_mul_f32 v[76:77], v[76:77], v[10:11] op_sel_hi:[1,0]
    v_pk_mul_f32 v[78:79], v[78:79], v[10:11] op_sel_hi:[1,0]
    v_cvt_pk_bf16_f32 v12, v72, v73
    v_cvt_pk_bf16_f32 v13, v74, v75
    v_cvt_pk_bf16_f32 v14, v76, v77
    v_cvt_pk_bf16_f32 v15, v78, v79
    v_pk_mul_f32 v[80:81], v[80:81], v[10:11] op_sel_hi:[1,0]
    v_pk_mul_f32 v[82:83], v[82:83], v[10:11] op_sel_hi:[1,0]
    v_pk_mul_f32 v[84:85], v[84:85], v[10:11] op_sel_hi:[1,0]
    v_pk_mul_f32 v[86:87], v[86:87], v[10:11] op_sel_hi:[1,0]
    v_cvt_pk_bf16_f32 v16, v80, v81
    v_cvt_pk_bf16_f32 v17, v82, v83
    v_cvt_pk_bf16_f32 v18, v84, v85
    v_cvt_pk_bf16_f32 v19, v86, v87
    v_pk_mul_f32 v[88:89], v[88:89], v[10:11] op_sel_hi:[1,0]
    v_pk_mul_f32 v[90:91], v[90:91], v[10:11] op_sel_hi:[1,0]
    v_pk_mul_f32 v[92:93], v[92:93], v[10:11] op_sel_hi:[1,0]
    v_pk_mul_f32 v[94:95], v[94:95], v[10:11] op_sel_hi:[1,0]
    v_cvt_pk_bf16_f32 v20, v88, v89
    v_cvt_pk_bf16_f32 v21, v90, v91
    v_cvt_pk_bf16_f32 v22, v92, v93
    v_cvt_pk_bf16_f32 v23, v94, v95
    v_pk_mul_f32 v[96:97], v[96:97], v[10:11] op_sel_hi:[1,0]
    v_pk_mul_f32 v[98:99], v[98:99], v[10:11] op_sel_hi:[1,0]
    v_pk_mul_f32 v[100:101], v[100:101], v[10:11] op_sel_hi:[1,0]
    v_pk_mul_f32 v[102:103], v[102:103], v[10:11] op_sel_hi:[1,0]
    v_cvt_pk_bf16_f32 v24, v96, v97
    v_cvt_pk_bf16_f32 v25, v98, v99
    v_cvt_pk_bf16_f32 v26, v100, v101
    v_cvt_pk_bf16_f32 v27, v102, v103
    v_pk_mul_f32 v[104:105], v[104:105], v[10:11] op_sel_hi:[1,0]
    v_pk_mul_f32 v[106:107], v[106:107], v[10:11] op_sel_hi:[1,0]
    v_pk_mul_f32 v[108:109], v[108:109], v[10:11] op_sel_hi:[1,0]
    v_pk_mul_f32 v[110:111], v[110:111], v[10:11] op_sel_hi:[1,0]
    v_cvt_pk_bf16_f32 v28, v104, v105
    v_cvt_pk_bf16_f32 v29, v106, v107
    v_cvt_pk_bf16_f32 v30, v108, v109
    v_cvt_pk_bf16_f32 v31, v110, v111
    s_cbranch_scc1 L_store
    s_waitcnt vmcnt(0)
L_store:
    global_store_dwordx4 v2, v[12:15], s[8:9] offset:0 nt
    global_store_dwordx4 v2, v[16:19], s[8:9] offset:256 nt
    global_store_dwordx4 v2, v[20:23], s[8:9] offset:512 nt
    global_store_dwordx4 v2, v[24:27], s[8:9] offset:768 nt
    global_store_dwordx4 v2, v[28:31], s[8:9] offset:1024 nt
L_end:
    s_endpgm
.section .rodata,"a"
.p2align 6
.amdhsa_kernel standalone__rmsnorm__sampling_kernel
  .amdhsa_next_free_vgpr 120
  .amdhsa_next_free_sgpr 18
  .amdhsa_accum_offset 120
  .amdhsa_group_segment_fixed_size 0
  .amdhsa_kernarg_size 40
  .amdhsa_user_sgpr_count 2
  .amdhsa_user_sgpr_kernarg_segment_ptr 1
  .amdhsa_system_sgpr_workgroup_id_x 1
  .amdhsa_float_denorm_mode_32 3
.end_amdhsa_kernel
```
